```python
import torch

def _softmax(x, axis=-1):
    return torch.softmax(x, dim=axis)
def _gelu(x):
    return torch.nn.functional.gelu(x, approximate="tanh")
def _silu(x):
    return torch.nn.functional.silu(x)
def _sigmoid(x):
    return torch.sigmoid(x)
def _layernorm(x, axis=-1, eps=1e-5):
    m = x.mean(dim=axis, keepdim=True)
    v = x.var(dim=axis, keepdim=True, unbiased=False)
    return (x - m) / torch.sqrt(v + eps)
def _scatter_add(tgt, idx, src, axis=0):
    return tgt.clone().index_add_(axis, idx, src)
def _segment_sum(src, seg, n):
    out = torch.zeros((n,) + src.shape[1:], dtype=src.dtype)
    return out.index_add_(0, seg, src)
def _pad(x, pw):
    flat = tuple(v for pair in reversed(pw) for v in pair)
    return torch.nn.functional.pad(x, flat)

kernel_name = 'standalone__paged_block_table_kv_radixattention__sampling'

def setup_inputs():

    _w = (lambda a: (lambda t: t.to(torch.bfloat16) if t.is_floating_point() else t)(torch.as_tensor(a)))
    B, H, Hkv, Dh = 8, 32, 32, 192
    Lk = 4096
    bs = 16
    nb = max(2, Lk // bs)
    P = max(1, nb // 2)
    n_phys = P + B * (nb - P)
    shared = torch.arange(P, dtype=torch.int64)
    priv = P + torch.arange(B * (nb - P), dtype=torch.int64).reshape(B, nb - P)
    bt = torch.cat([torch.tile(shared[None, :], (B, 1)), priv], dim=1)
    ctx = nb * bs - (torch.arange(1, B + 1, dtype=torch.int64) * 2654435761) % max(1, (nb * bs - P * bs) // 2)
    return {
        "q": _w((lambda *s: torch.randn(*s, dtype=torch.bfloat16) * 0.8)(B, H, Dh)),
        "k_cache": _w((lambda *s: torch.randn(*s, dtype=torch.bfloat16) * 0.8)(n_phys, bs, Hkv, Dh)),
        "v_cache": _w((lambda *s: torch.randn(*s, dtype=torch.bfloat16) * 0.05)(n_phys, bs, Hkv, Dh)),
        "block_table": _w(bt.to(torch.int64)),
        "ctx_lens": _w(torch.as_tensor(ctx).to(torch.int64)),
    }

def reference(q, k_cache, v_cache, block_table, ctx_lens):
    B, H, Dh = q.shape
    n_phys, bs, Hkv, _ = k_cache.shape
    nb = block_table.shape[1]
    Lk = nb * bs
    rep = H // Hkv
    k = k_cache[block_table].reshape(B, Lk, Hkv, Dh)
    v = v_cache[block_table].reshape(B, Lk, Hkv, Dh)
    k = (lambda x, n, axis: torch.repeat_interleave(x, n, dim=axis))(k, rep, axis=2)
    v = (lambda x, n, axis: torch.repeat_interleave(x, n, dim=axis))(v, rep, axis=2)
    scores = torch.einsum("bhd,bkhd->bhk", q, k) * (Dh ** -0.5)
    pos = torch.arange(Lk)
    valid = pos[None, :] < ctx_lens[:, None]
    scores = torch.where(valid[:, None, :], scores, -1e9)
    p = _softmax(scores, axis=-1)
    return torch.einsum("bhk,bkhd->bhd", p, v)
```

```asm
; @launch grid=(256,1,1) block=(512,1,1) lds=40768
.amdgcn_target "amdgcn-amd-amdhsa--gfx950"
.text
.globl standalone__paged_block_table_kv_radixattention__sampling_kernel
.p2align 8
.type standalone__paged_block_table_kv_radixattention__sampling_kernel,@function
standalone__paged_block_table_kv_radixattention__sampling_kernel:
    s_cmp_ge_u32 s2, 256
    s_cbranch_scc1 A_end
    v_lshrrev_b32 v15, 6, v0
    v_and_b32 v1, 63, v0
    v_readfirstlane_b32 s86, v15
    s_lshr_b32 s96, s2, 3
    s_and_b32 s88, s2, 7
    s_cmp_ge_u32 s86, 4
    s_cbranch_scc1 P_start
    s_load_dwordx16 s[4:19], s[0:1], 0
    v_and_b32 v2, 15, v0
    v_lshrrev_b32 v3, 4, v1
    s_lshl_b32 s59, s96, 12
    s_add_u32 s59, s59, 1835008
    s_mul_i32 s87, s96, 384
    s_lshl_b32 s95, s88, 2
    s_lshl_b32 s93, s88, 10
    v_and_b32 v4, 2, v2
    v_lshrrev_b32 v15, 2, v2
    v_lshl_add_u32 v4, v4, 1, v15
    v_mul_u32_u24 v4, 12288, v4
    v_lshl_add_u32 v4, v3, 5, v4
    v_and_b32 v15, 1, v2
    v_lshl_add_u32 v4, v15, 4, v4
    v_mul_u32_u24 v15, 12288, v3
    v_lshl_add_u32 v5, v2, 4, v15
    v_lshl_add_u32 v6, v2, 3, v15
    v_and_b32 v44, 7, v2
    v_mul_u32_u24 v45, 12288, v44
    v_lshl_add_u32 v45, v3, 5, v45
    v_lshrrev_b32 v47, 3, v2
    v_lshl_add_u32 v45, v47, 4, v45
    v_add_u32 v45, s87, v45
    s_mul_i32 s94, s86, 6272
    v_mul_u32_u24 v43, 784, v44
    v_lshl_add_u32 v43, v47, 6, v43
    v_lshl_add_u32 v43, v3, 4, v43
    v_add_u32 v43, s94, v43
    v_lshlrev_b32 v44, 2, v44
    v_lshl_add_u32 v100, v1, 4, s93
    s_mov_b32 s22, 226492416
    s_mov_b32 s23, 0x20000
    s_mov_b32 s26, 226492416
    s_mov_b32 s27, 0x20000
    s_barrier
    s_waitcnt lgkmcnt(0)
    s_load_dword s94, s[12:13], s95
    global_load_dword v7, v44, s[12:13]
    global_load_dwordx4 v[16:19], v45, s[4:5] offset:0
    global_load_dwordx4 v[20:23], v45, s[4:5] offset:128
    global_load_dwordx4 v[24:27], v45, s[4:5] offset:256
    s_mov_b32 s20, s6
    s_and_b32 s21, s7, 0xffff
    s_mov_b32 s24, s8
    s_and_b32 s25, s9, 0xffff
    s_add_u32 s6, s18, s59
    s_addc_u32 s7, s19, 0
    s_mov_b32 s64, 0x3dd53b95
    s_mov_b32 s65, 0x05040100
    s_mov_b32 s66, 0x07060302
    v_mov_b32 v9, 0xff61b1e6
    v_mul_f32 v10, s64, v9
    v_mov_b32 v11, 0
    v_mov_b32 v12, 0xff800000
    v_mov_b32 v8, 0
    v_mov_b32 v122, 0
    v_mov_b32 v48, 0
    v_mov_b32 v49, 0
    v_mov_b32 v50, 0
    v_mov_b32 v51, 0
    v_mov_b32 v52, 0
    v_mov_b32 v53, 0
    v_mov_b32 v54, 0
    v_mov_b32 v55, 0
    v_mov_b32 v56, 0
    v_mov_b32 v57, 0
    v_mov_b32 v58, 0
    v_mov_b32 v59, 0
    v_mov_b32 v60, 0
    v_mov_b32 v61, 0
    v_mov_b32 v62, 0
    v_mov_b32 v63, 0
    v_mov_b32 v64, 0
    v_mov_b32 v65, 0
    v_mov_b32 v66, 0
    v_mov_b32 v67, 0
    v_mov_b32 v68, 0
    v_mov_b32 v69, 0
    v_mov_b32 v70, 0
    v_mov_b32 v71, 0
    s_waitcnt lgkmcnt(0)
    s_cmp_lt_i32 s94, 1
    s_cselect_b32 s94, 0x1000, s94
    s_min_i32 s94, s94, 0x1000
    s_add_u32 s94, s94, 15
    s_lshr_b32 s94, s94, 4
    s_sub_u32 s94, s94, s86
    s_sub_u32 s36, s94, 9
    s_max_i32 s95, s36, 0
    s_lshl_b32 s95, s95, 2
    s_add_u32 s95, s95, s93
    s_load_dword s68, s[10:11], s95
    s_sub_u32 s37, s94, 13
    s_max_i32 s95, s37, 0
    s_lshl_b32 s95, s95, 2
    s_add_u32 s95, s95, s93
    s_load_dword s69, s[10:11], s95
    s_sub_u32 s38, s94, 1
    s_max_i32 s95, s38, 0
    s_lshl_b32 s95, s95, 2
    s_add_u32 s95, s95, s93
    s_load_dword s70, s[10:11], s95
    s_sub_u32 s39, s94, 5
    s_max_i32 s95, s39, 0
    s_lshl_b32 s95, s95, 2
    s_add_u32 s95, s95, s93
    s_load_dword s71, s[10:11], s95
    s_waitcnt lgkmcnt(0)
    s_and_b32 s94, s68, 0xffff
    s_mul_i32 s94, s94, 196608
    s_add_u32 s94, s94, s87
    s_cmp_ge_i32 s36, 0
    s_cselect_b32 s60, s94, 0xf0000000
    s_add_u32 s61, s60, 49152
    s_add_u32 s62, s60, 98304
    s_add_u32 s63, s60, 147456
    buffer_load_dwordx4 a[0:3], v4, s[20:23], s60 offen offset:0 nt
    buffer_load_dwordx4 a[4:7], v4, s[20:23], s60 offen offset:128 nt
    buffer_load_dwordx4 a[8:11], v4, s[20:23], s60 offen offset:256 nt
    buffer_load_dwordx4 a[12:15], v4, s[20:23], s62 offen offset:0 nt
    buffer_load_dwordx4 a[16:19], v4, s[20:23], s62 offen offset:128 nt
    buffer_load_dwordx4 a[20:23], v4, s[20:23], s62 offen offset:256 nt
    s_lshl_b32 s93, 0x1000000, s88
    s_and_b32 s94, s68, 0xffff
    s_lshl_b32 s95, s36, 16
    s_or_b32 s94, s94, s95
    s_or_b32 s94, s94, s93
    s_cmp_ge_i32 s36, 0
    s_cselect_b32 s32, s94, 0
    s_and_b32 s94, s69, 0xffff
    s_lshl_b32 s95, s37, 16
    s_or_b32 s94, s94, s95
    s_or_b32 s94, s94, s93
    s_cmp_ge_i32 s37, 0
    s_cselect_b32 s69, s94, 0
    v_writelane_b32 v8, s69, 1
    s_and_b32 s94, s70, 0xffff
    s_lshl_b32 s95, s38, 16
    s_or_b32 s94, s94, s95
    s_or_b32 s94, s94, s93
    s_cmp_ge_i32 s38, 0
    s_cselect_b32 s70, s94, 0
    v_writelane_b32 v122, s70, 0
    s_and_b32 s94, s71, 0xffff
    s_lshl_b32 s95, s39, 16
    s_or_b32 s94, s94, s95
    s_or_b32 s94, s94, s93
    s_cmp_ge_i32 s39, 0
    s_cselect_b32 s71, s94, 0
    v_writelane_b32 v122, s71, 1
    v_mov_b32 v72, 0
    v_mov_b32 v73, 0
    v_mov_b32 v74, 0
    v_mov_b32 v75, 0
    v_mov_b32 v76, 0
    v_mov_b32 v77, 0
    v_mov_b32 v78, 0
    v_mov_b32 v79, 0
    v_mov_b32 v80, 0
    v_mov_b32 v81, 0
    v_mov_b32 v82, 0
    v_mov_b32 v83, 0
    v_mov_b32 v84, 0
    v_mov_b32 v85, 0
    v_mov_b32 v86, 0
    v_mov_b32 v87, 0
    v_mov_b32 v88, 0
    v_mov_b32 v89, 0
    v_mov_b32 v90, 0
    v_mov_b32 v91, 0
    v_mov_b32 v92, 0
    v_mov_b32 v93, 0
    v_mov_b32 v94, 0
    v_mov_b32 v95, 0
    s_lshl_b32 s76, 0x10001, s88
    s_mov_b32 s77, s76
    s_mul_i32 s94, s86, 768
    v_lshl_add_u32 v123, v3, 4, s94
    s_waitcnt vmcnt(6)
    v_cmp_gt_i32 vcc, 1, v7
    v_mov_b32 v15, 0x1000
    v_lshlrev_b32 v42, 0, v3
    v_cndmask_b32 v7, v7, v15, vcc
    v_cndmask_b32_e64 v16, v16, 0, vcc
    v_cndmask_b32_e64 v17, v17, 0, vcc
    v_cndmask_b32_e64 v18, v18, 0, vcc
    v_cndmask_b32_e64 v19, v19, 0, vcc
    v_cndmask_b32_e64 v20, v20, 0, vcc
    v_cndmask_b32_e64 v21, v21, 0, vcc
    v_cndmask_b32_e64 v22, v22, 0, vcc
    v_cndmask_b32_e64 v23, v23, 0, vcc
    v_cndmask_b32_e64 v24, v24, 0, vcc
    v_cndmask_b32_e64 v25, v25, 0, vcc
    v_cndmask_b32_e64 v26, v26, 0, vcc
    v_cndmask_b32_e64 v27, v27, 0, vcc
    v_sub_u32 v7, v7, v42
    s_mov_b32 s92, 0
    s_mov_b32 s33, 0
    s_mov_b32 s91, 0x7fffffff
    s_mov_b32 s34, 0x7fffffff
    s_mov_b32 s90, 3
    s_waitcnt vmcnt(5)
    buffer_load_dwordx4 v[124:127], v5, s[24:27], s60 offen nt
    s_waitcnt vmcnt(5)
    buffer_load_dwordx2 v[140:141], v6, s[24:27], s60 offen offset:256 nt
    s_waitcnt vmcnt(5)
    buffer_load_dwordx4 v[128:131], v5, s[24:27], s61 offen nt
    s_waitcnt vmcnt(6)
    buffer_load_dwordx2 v[142:143], v6, s[24:27], s61 offen offset:256 nt
    s_waitcnt vmcnt(6)
    buffer_load_dwordx4 v[132:135], v5, s[24:27], s62 offen nt
    s_waitcnt vmcnt(6)
    buffer_load_dwordx2 v[144:145], v6, s[24:27], s62 offen offset:256 nt
    s_waitcnt vmcnt(6)
    buffer_load_dwordx4 v[136:139], v5, s[24:27], s63 offen nt
    s_waitcnt vmcnt(7)
    buffer_load_dwordx2 v[146:147], v6, s[24:27], s63 offen offset:256 nt
A_loop:
    s_bfe_u32 s58, s32, 0x80010
    s_lshl_b32 s58, s58, 4
    s_lshr_b32 s48, s32, 24
    s_mul_i32 s48, s48, 0x10001
    s_mov_b32 s49, s48
    s_add_u32 s93, s92, 1
    v_readlane_b32 s32, v8, s93
    s_add_u32 s94, s93, 1
    s_cmp_ge_u32 s94, s90
    s_cbranch_scc1 A_dyn
A_rec:
    s_and_b32 s94, s32, 0xffff
    s_mul_i32 s94, s94, 196608
    s_add_u32 s94, s94, s87
    s_cmp_lg_u32 s32, 0
    s_cselect_b32 s60, s94, 0xf0000000
    s_add_u32 s61, s60, 49152
    s_add_u32 s62, s60, 98304
    s_add_u32 s63, s60, 147456
    v_subrev_u32 v13, s58, v7
    v_cndmask_b32_e64 v13, 0, v13, s[48:49]
    v_cmp_lt_i32_e64 s[50:51], 0, v13
    v_cmp_lt_i32_e64 s[52:53], 4, v13
    v_cmp_lt_i32_e64 s[54:55], 8, v13
    v_cmp_lt_i32_e64 s[56:57], 12, v13
    s_waitcnt vmcnt(8)
    v_mfma_f32_16x16x32_bf16 v[28:31], a[0:3], v[16:19], 0
    v_mfma_f32_16x16x32_bf16 v[32:35], a[12:15], v[16:19], 0
    v_mfma_f32_16x16x32_bf16 v[28:31], a[4:7], v[20:23], v[28:31]
    v_mfma_f32_16x16x32_bf16 v[32:35], a[16:19], v[20:23], v[32:35]
    v_mfma_f32_16x16x32_bf16 v[28:31], a[8:11], v[24:27], v[28:31]
    v_mfma_f32_16x16x32_bf16 v[32:35], a[20:23], v[24:27], v[32:35]
    s_waitcnt vmcnt(6)
    buffer_load_dwordx4 a[0:3], v4, s[20:23], s60 offen offset:0 nt
    s_waitcnt vmcnt(6)
    buffer_load_dwordx4 a[4:7], v4, s[20:23], s60 offen offset:128 nt
    s_nop 6
    v_add_f32_dpp v36, v29, v28 row_ror:8 row_mask:0xf bank_mask:0xf
    v_add_f32_dpp v37, v31, v30 row_ror:8 row_mask:0xf bank_mask:0xf
    v_add_f32_dpp v38, v33, v32 row_ror:8 row_mask:0xf bank_mask:0xf
    v_add_f32_dpp v39, v35, v34 row_ror:8 row_mask:0xf bank_mask:0xf
    v_cndmask_b32_e64 v36, v12, v36, s[50:51]
    v_cndmask_b32_e64 v37, v12, v37, s[52:53]
    v_cndmask_b32_e64 v38, v12, v38, s[54:55]
    v_cndmask_b32_e64 v39, v12, v39, s[56:57]
    v_max3_f32 v14, v36, v37, v38
    v_max_f32 v14, v14, v39
    v_cmp_gt_f32 vcc, v14, v9
    s_cbranch_vccnz A_slowA
A_backA:
    v_fma_f32 v44, v36, s64, -v10
    v_fma_f32 v45, v37, s64, -v10
    v_fma_f32 v46, v38, s64, -v10
    v_fma_f32 v47, v39, s64, -v10
    v_exp_f32 v44, v44
    v_exp_f32 v45, v45
    v_exp_f32 v46, v46
    v_exp_f32 v47, v47
    s_waitcnt vmcnt(6)
    buffer_load_dwordx4 a[8:11], v4, s[20:23], s60 offen offset:256 nt
    s_waitcnt vmcnt(5)
    buffer_load_dwordx4 a[12:15], v4, s[20:23], s62 offen offset:0 nt
    s_waitcnt vmcnt(5)
    buffer_load_dwordx4 a[16:19], v4, s[20:23], s62 offen offset:128 nt
    s_waitcnt vmcnt(5)
    buffer_load_dwordx4 a[20:23], v4, s[20:23], s62 offen offset:256 nt
    v_cvt_pk_bf16_f32 v40, v44, v45
    v_cvt_pk_bf16_f32 v41, v46, v47
    v_add_f32 v44, v44, v45
    v_add_f32 v46, v46, v47
    v_add_f32 v11, v11, v44
    v_add_f32 v11, v11, v46
    s_waitcnt vmcnt(6)
    v_perm_b32 v96, v128, v124, s65
    v_perm_b32 v97, v136, v132, s65
    v_perm_b32 v98, v128, v124, s66
    v_perm_b32 v99, v136, v132, s66
    v_perm_b32 v100, v129, v125, s65
    v_perm_b32 v101, v137, v133, s65
    v_perm_b32 v102, v129, v125, s66
    v_perm_b32 v103, v137, v133, s66
    v_perm_b32 v104, v130, v126, s65
    v_perm_b32 v105, v138, v134, s65
    v_perm_b32 v106, v130, v126, s66
    v_perm_b32 v107, v138, v134, s66
    v_perm_b32 v108, v131, v127, s65
    v_perm_b32 v109, v139, v135, s65
    v_perm_b32 v110, v131, v127, s66
    v_perm_b32 v111, v139, v135, s66
    v_perm_b32 v112, v142, v140, s65
    v_perm_b32 v113, v146, v144, s65
    v_perm_b32 v114, v142, v140, s66
    v_perm_b32 v115, v146, v144, s66
    v_perm_b32 v116, v143, v141, s65
    v_perm_b32 v117, v147, v145, s65
    v_perm_b32 v118, v143, v141, s66
    v_perm_b32 v119, v147, v145, s66
    s_waitcnt vmcnt(5)
    buffer_load_dwordx4 v[124:127], v5, s[24:27], s60 offen nt
    s_waitcnt vmcnt(5)
    buffer_load_dwordx2 v[140:141], v6, s[24:27], s60 offen offset:256 nt
    v_mfma_f32_16x16x16_bf16 v[48:51], v[96:97], v[40:41], v[48:51]
    v_mfma_f32_16x16x16_bf16 v[52:55], v[98:99], v[40:41], v[52:55]
    v_mfma_f32_16x16x16_bf16 v[56:59], v[100:101], v[40:41], v[56:59]
    v_mfma_f32_16x16x16_bf16 v[60:63], v[102:103], v[40:41], v[60:63]
    v_mfma_f32_16x16x16_bf16 v[64:67], v[104:105], v[40:41], v[64:67]
    v_mfma_f32_16x16x16_bf16 v[68:71], v[106:107], v[40:41], v[68:71]
    v_mfma_f32_16x16x16_bf16 v[72:75], v[108:109], v[40:41], v[72:75]
    v_mfma_f32_16x16x16_bf16 v[76:79], v[110:111], v[40:41], v[76:79]
    v_mfma_f32_16x16x16_bf16 v[80:83], v[112:113], v[40:41], v[80:83]
    v_mfma_f32_16x16x16_bf16 v[84:87], v[114:115], v[40:41], v[84:87]
    v_mfma_f32_16x16x16_bf16 v[88:91], v[116:117], v[40:41], v[88:91]
    v_mfma_f32_16x16x16_bf16 v[92:95], v[118:119], v[40:41], v[92:95]
    s_add_u32 s92, s92, 1
    s_cmp_eq_u32 s92, s34
    s_cbranch_scc1 A_last
    s_waitcnt vmcnt(5)
    buffer_load_dwordx4 v[128:131], v5, s[24:27], s61 offen nt
    s_waitcnt vmcnt(6)
    buffer_load_dwordx2 v[142:143], v6, s[24:27], s61 offen offset:256 nt
    s_waitcnt vmcnt(6)
    buffer_load_dwordx4 v[132:135], v5, s[24:27], s62 offen nt
    s_waitcnt vmcnt(6)
    buffer_load_dwordx2 v[144:145], v6, s[24:27], s62 offen offset:256 nt
    s_waitcnt vmcnt(6)
    buffer_load_dwordx4 v[136:139], v5, s[24:27], s63 offen nt
    s_waitcnt vmcnt(7)
    buffer_load_dwordx2 v[146:147], v6, s[24:27], s63 offen offset:256 nt
A_cont:
    s_cmp_lt_u32 s92, s91
    s_cbranch_scc1 A_loop
    s_bfe_u32 s58, s32, 0x80010
    s_lshl_b32 s58, s58, 4
    s_lshr_b32 s48, s32, 24
    s_mul_i32 s48, s48, 0x10001
    s_mov_b32 s49, s48
    v_subrev_u32 v13, s58, v7
    v_cndmask_b32_e64 v13, 0, v13, s[48:49]
    v_cmp_lt_i32_e64 s[50:51], 0, v13
    v_cmp_lt_i32_e64 s[52:53], 4, v13
    v_cmp_lt_i32_e64 s[54:55], 8, v13
    v_cmp_lt_i32_e64 s[56:57], 12, v13
    s_waitcnt vmcnt(8)
    v_mfma_f32_16x16x32_bf16 v[28:31], a[0:3], v[16:19], 0
    v_mfma_f32_16x16x32_bf16 v[32:35], a[12:15], v[16:19], 0
    v_mfma_f32_16x16x32_bf16 v[28:31], a[4:7], v[20:23], v[28:31]
    v_mfma_f32_16x16x32_bf16 v[32:35], a[16:19], v[20:23], v[32:35]
    v_mfma_f32_16x16x32_bf16 v[28:31], a[8:11], v[24:27], v[28:31]
    v_mfma_f32_16x16x32_bf16 v[32:35], a[20:23], v[24:27], v[32:35]
    s_nop 8
    v_add_f32_dpp v36, v29, v28 row_ror:8 row_mask:0xf bank_mask:0xf
    v_add_f32_dpp v37, v31, v30 row_ror:8 row_mask:0xf bank_mask:0xf
    v_add_f32_dpp v38, v33, v32 row_ror:8 row_mask:0xf bank_mask:0xf
    v_add_f32_dpp v39, v35, v34 row_ror:8 row_mask:0xf bank_mask:0xf
    v_cndmask_b32_e64 v36, v12, v36, s[50:51]
    v_cndmask_b32_e64 v37, v12, v37, s[52:53]
    v_cndmask_b32_e64 v38, v12, v38, s[54:55]
    v_cndmask_b32_e64 v39, v12, v39, s[56:57]
    v_max3_f32 v14, v36, v37, v38
    v_max_f32 v14, v14, v39
    v_cmp_gt_f32 vcc, v14, v9
    s_cbranch_vccnz A_slowZ
A_backZ:
    v_fma_f32 v44, v36, s64, -v10
    v_fma_f32 v45, v37, s64, -v10
    v_fma_f32 v46, v38, s64, -v10
    v_fma_f32 v47, v39, s64, -v10
    v_exp_f32 v44, v44
    v_exp_f32 v45, v45
    v_exp_f32 v46, v46
    v_exp_f32 v47, v47
    s_nop 0
    v_cvt_pk_bf16_f32 v40, v44, v45
    v_cvt_pk_bf16_f32 v41, v46, v47
    v_add_f32 v44, v44, v45
    v_add_f32 v46, v46, v47
    v_add_f32 v11, v11, v44
    v_add_f32 v11, v11, v46
    v_mov_b32 v15, v11
    v_mov_b32 v42, v11
    s_nop 1
    v_permlane32_swap_b32 v15, v42
    s_nop 1
    v_add_f32 v11, v15, v42
    v_mov_b32 v15, v11
    v_mov_b32 v42, v11
    s_nop 1
    v_permlane16_swap_b32 v15, v42
    s_nop 1
    v_add_f32 v11, v15, v42
    s_lshl_b32 s93, s86, 3
    v_mov_b32 v45, s93
    s_lshl_b32 s93, s86, 2
    v_mov_b32 v46, s93
    v_mov_b32 v47, 1
    s_mov_b64 exec, s[76:77]
    ds_write_b64 v45, v[10:11] offset:15360
    s_mov_b64 exec, -1
    s_waitcnt vmcnt(0)
    v_perm_b32 v96, v128, v124, s65
    v_perm_b32 v97, v136, v132, s65
    v_perm_b32 v98, v128, v124, s66
    v_perm_b32 v99, v136, v132, s66
    v_perm_b32 v100, v129, v125, s65
    v_perm_b32 v101, v137, v133, s65
    v_mfma_f32_16x16x16_bf16 v[48:51], v[96:97], v[40:41], v[48:51]
    v_perm_b32 v102, v129, v125, s66
    v_perm_b32 v103, v137, v133, s66
    v_mfma_f32_16x16x16_bf16 v[52:55], v[98:99], v[40:41], v[52:55]
    v_perm_b32 v104, v130, v126, s65
    v_perm_b32 v105, v138, v134, s65
    v_mfma_f32_16x16x16_bf16 v[56:59], v[100:101], v[40:41], v[56:59]
    v_perm_b32 v106, v130, v126, s66
    v_perm_b32 v107, v138, v134, s66
    v_mfma_f32_16x16x16_bf16 v[60:63], v[102:103], v[40:41], v[60:63]
    v_perm_b32 v108, v131, v127, s65
    v_perm_b32 v109, v139, v135, s65
    v_mfma_f32_16x16x16_bf16 v[64:67], v[104:105], v[40:41], v[64:67]
    v_perm_b32 v110, v131, v127, s66
    v_perm_b32 v111, v139, v135, s66
    v_mfma_f32_16x16x16_bf16 v[68:71], v[106:107], v[40:41], v[68:71]
    v_perm_b32 v112, v142, v140, s65
    v_perm_b32 v113, v146, v144, s65
    v_mfma_f32_16x16x16_bf16 v[72:75], v[108:109], v[40:41], v[72:75]
    v_perm_b32 v114, v142, v140, s66
    v_perm_b32 v115, v146, v144, s66
    v_mfma_f32_16x16x16_bf16 v[76:79], v[110:111], v[40:41], v[76:79]
    v_perm_b32 v116, v143, v141, s65
    v_perm_b32 v117, v147, v145, s65
    v_mfma_f32_16x16x16_bf16 v[80:83], v[112:113], v[40:41], v[80:83]
    v_perm_b32 v118, v143, v141, s66
    v_perm_b32 v119, v147, v145, s66
    v_mfma_f32_16x16x16_bf16 v[84:87], v[114:115], v[40:41], v[84:87]
    v_mfma_f32_16x16x16_bf16 v[88:91], v[116:117], v[40:41], v[88:91]
    v_mfma_f32_16x16x16_bf16 v[92:95], v[118:119], v[40:41], v[92:95]
    s_mov_b64 exec, s[76:77]
    ds_write_b128 v123, v[48:51] offset:12288
    ds_write_b128 v123, v[52:55] offset:12352
    ds_write_b128 v123, v[56:59] offset:12416
    ds_write_b128 v123, v[60:63] offset:12480
    s_nop 3
    ds_write_b128 v123, v[64:67] offset:12544
    ds_write_b128 v123, v[68:71] offset:12608
    ds_write_b128 v123, v[72:75] offset:12672
    ds_write_b128 v123, v[76:79] offset:12736
    ds_write_b128 v123, v[80:83] offset:12800
    ds_write_b128 v123, v[84:87] offset:12864
    ds_write_b128 v123, v[88:91] offset:12928
    ds_write_b128 v123, v[92:95] offset:12992
    s_waitcnt lgkmcnt(0)
    ds_write_b32 v46, v47 offset:8352
A_end:
    s_endpgm
A_last:
    s_waitcnt vmcnt(5)
    buffer_load_dwordx4 v[128:131], v5, s[24:27], s61 offen nt
    v_mov_b32 v15, v11
    v_mov_b32 v42, v11
    s_nop 1
    v_permlane32_swap_b32 v15, v42
    s_nop 1
    v_add_f32 v121, v15, v42
    v_mov_b32 v15, v121
    v_mov_b32 v42, v121
    s_nop 1
    v_permlane16_swap_b32 v15, v42
    s_nop 1
    v_add_f32 v121, v15, v42
    v_mov_b32 v120, v10
    s_lshl_b32 s93, s86, 6
    v_lshl_add_u32 v44, v1, 3, s93
    s_mov_b64 exec, 0xff
    ds_write_b64 v44, v[120:121] offset:15424
    s_mov_b64 exec, -1
    v_mov_b32_dpp v48, v52 row_ror:8 row_mask:0xf bank_mask:0xc
    v_mov_b32_dpp v49, v53 row_ror:8 row_mask:0xf bank_mask:0xc
    v_mov_b32_dpp v50, v54 row_ror:8 row_mask:0xf bank_mask:0xc
    v_mov_b32_dpp v51, v55 row_ror:8 row_mask:0xf bank_mask:0xc
    ds_write_b128 v43, v[48:51] offset:15680
    v_mov_b32_dpp v56, v60 row_ror:8 row_mask:0xf bank_mask:0xc
    v_mov_b32_dpp v57, v61 row_ror:8 row_mask:0xf bank_mask:0xc
    v_mov_b32_dpp v58, v62 row_ror:8 row_mask:0xf bank_mask:0xc
    v_mov_b32_dpp v59, v63 row_ror:8 row_mask:0xf bank_mask:0xc
    ds_write_b128 v43, v[56:59] offset:15808
    v_mov_b32_dpp v64, v68 row_ror:8 row_mask:0xf bank_mask:0xc
    v_mov_b32_dpp v65, v69 row_ror:8 row_mask:0xf bank_mask:0xc
    v_mov_b32_dpp v66, v70 row_ror:8 row_mask:0xf bank_mask:0xc
    v_mov_b32_dpp v67, v71 row_ror:8 row_mask:0xf bank_mask:0xc
    ds_write_b128 v43, v[64:67] offset:15936
    v_mov_b32_dpp v72, v76 row_ror:8 row_mask:0xf bank_mask:0xc
    v_mov_b32_dpp v73, v77 row_ror:8 row_mask:0xf bank_mask:0xc
    v_mov_b32_dpp v74, v78 row_ror:8 row_mask:0xf bank_mask:0xc
    v_mov_b32_dpp v75, v79 row_ror:8 row_mask:0xf bank_mask:0xc
    ds_write_b128 v43, v[72:75] offset:16064
    v_mov_b32_dpp v80, v84 row_ror:8 row_mask:0xf bank_mask:0xc
    v_mov_b32_dpp v81, v85 row_ror:8 row_mask:0xf bank_mask:0xc
    v_mov_b32_dpp v82, v86 row_ror:8 row_mask:0xf bank_mask:0xc
    v_mov_b32_dpp v83, v87 row_ror:8 row_mask:0xf bank_mask:0xc
    ds_write_b128 v43, v[80:83] offset:16192
    v_mov_b32_dpp v88, v92 row_ror:8 row_mask:0xf bank_mask:0xc
    v_mov_b32_dpp v89, v93 row_ror:8 row_mask:0xf bank_mask:0xc
    v_mov_b32_dpp v90, v94 row_ror:8 row_mask:0xf bank_mask:0xc
    v_mov_b32_dpp v91, v95 row_ror:8 row_mask:0xf bank_mask:0xc
    ds_write_b128 v43, v[88:91] offset:16320
    s_lshl_b32 s93, s86, 2
    v_mov_b32 v44, s93
    v_mov_b32 v45, 1
    s_waitcnt lgkmcnt(0)
    ds_write_b32 v44, v45 offset:8336
    s_waitcnt vmcnt(6)
    buffer_load_dwordx2 v[142:143], v6, s[24:27], s61 offen offset:256 nt
    s_waitcnt vmcnt(6)
    buffer_load_dwordx4 v[132:135], v5, s[24:27], s62 offen nt
    s_waitcnt vmcnt(6)
    buffer_load_dwordx2 v[144:145], v6, s[24:27], s62 offen offset:256 nt
    s_waitcnt vmcnt(6)
    buffer_load_dwordx4 v[136:139], v5, s[24:27], s63 offen nt
    s_waitcnt vmcnt(7)
    buffer_load_dwordx2 v[146:147], v6, s[24:27], s63 offen offset:256 nt
    s_branch A_cont
A_slowA:
    v_mov_b32 v15, v14
    v_mov_b32 v42, v14
    s_nop 1
    v_permlane32_swap_b32 v15, v42
    s_nop 1
    v_max_f32 v14, v15, v42
    v_mov_b32 v15, v14
    v_mov_b32 v42, v14
    s_nop 1
    v_permlane16_swap_b32 v15, v42
    s_nop 1
    v_max_f32 v14, v15, v42
    v_max_f32 v9, v9, v14
    v_mul_f32 v15, s64, v9
    v_sub_f32 v42, v10, v15
    v_exp_f32 v42, v42
    v_mov_b32 v10, v15
    v_mul_f32 v11, v11, v42
    v_pk_mul_f32 v[48:49], v[48:49], v[42:43] op_sel_hi:[1,0]
    v_pk_mul_f32 v[50:51], v[50:51], v[42:43] op_sel_hi:[1,0]
    v_pk_mul_f32 v[52:53], v[52:53], v[42:43] op_sel_hi:[1,0]
    v_pk_mul_f32 v[54:55], v[54:55], v[42:43] op_sel_hi:[1,0]
    v_pk_mul_f32 v[56:57], v[56:57], v[42:43] op_sel_hi:[1,0]
    v_pk_mul_f32 v[58:59], v[58:59], v[42:43] op_sel_hi:[1,0]
    v_pk_mul_f32 v[60:61], v[60:61], v[42:43] op_sel_hi:[1,0]
    v_pk_mul_f32 v[62:63], v[62:63], v[42:43] op_sel_hi:[1,0]
    v_pk_mul_f32 v[64:65], v[64:65], v[42:43] op_sel_hi:[1,0]
    v_pk_mul_f32 v[66:67], v[66:67], v[42:43] op_sel_hi:[1,0]
    v_pk_mul_f32 v[68:69], v[68:69], v[42:43] op_sel_hi:[1,0]
    v_pk_mul_f32 v[70:71], v[70:71], v[42:43] op_sel_hi:[1,0]
    v_pk_mul_f32 v[72:73], v[72:73], v[42:43] op_sel_hi:[1,0]
    v_pk_mul_f32 v[74:75], v[74:75], v[42:43] op_sel_hi:[1,0]
    v_pk_mul_f32 v[76:77], v[76:77], v[42:43] op_sel_hi:[1,0]
    v_pk_mul_f32 v[78:79], v[78:79], v[42:43] op_sel_hi:[1,0]
    v_pk_mul_f32 v[80:81], v[80:81], v[42:43] op_sel_hi:[1,0]
    v_pk_mul_f32 v[82:83], v[82:83], v[42:43] op_sel_hi:[1,0]
    v_pk_mul_f32 v[84:85], v[84:85], v[42:43] op_sel_hi:[1,0]
    v_pk_mul_f32 v[86:87], v[86:87], v[42:43] op_sel_hi:[1,0]
    v_pk_mul_f32 v[88:89], v[88:89], v[42:43] op_sel_hi:[1,0]
    v_pk_mul_f32 v[90:91], v[90:91], v[42:43] op_sel_hi:[1,0]
    v_pk_mul_f32 v[92:93], v[92:93], v[42:43] op_sel_hi:[1,0]
    v_pk_mul_f32 v[94:95], v[94:95], v[42:43] op_sel_hi:[1,0]
    s_branch A_backA
A_slowZ:
    v_mov_b32 v15, v14
    v_mov_b32 v42, v14
    s_nop 1
    v_permlane32_swap_b32 v15, v42
    s_nop 1
    v_max_f32 v14, v15, v42
    v_mov_b32 v15, v14
    v_mov_b32 v42, v14
    s_nop 1
    v_permlane16_swap_b32 v15, v42
    s_nop 1
    v_max_f32 v14, v15, v42
    v_max_f32 v9, v9, v14
    v_mul_f32 v15, s64, v9
    v_sub_f32 v42, v10, v15
    v_exp_f32 v42, v42
    v_mov_b32 v10, v15
    v_mul_f32 v11, v11, v42
    v_pk_mul_f32 v[48:49], v[48:49], v[42:43] op_sel_hi:[1,0]
    v_pk_mul_f32 v[50:51], v[50:51], v[42:43] op_sel_hi:[1,0]
    v_pk_mul_f32 v[52:53], v[52:53], v[42:43] op_sel_hi:[1,0]
    v_pk_mul_f32 v[54:55], v[54:55], v[42:43] op_sel_hi:[1,0]
    v_pk_mul_f32 v[56:57], v[56:57], v[42:43] op_sel_hi:[1,0]
    v_pk_mul_f32 v[58:59], v[58:59], v[42:43] op_sel_hi:[1,0]
    v_pk_mul_f32 v[60:61], v[60:61], v[42:43] op_sel_hi:[1,0]
    v_pk_mul_f32 v[62:63], v[62:63], v[42:43] op_sel_hi:[1,0]
    v_pk_mul_f32 v[64:65], v[64:65], v[42:43] op_sel_hi:[1,0]
    v_pk_mul_f32 v[66:67], v[66:67], v[42:43] op_sel_hi:[1,0]
    v_pk_mul_f32 v[68:69], v[68:69], v[42:43] op_sel_hi:[1,0]
    v_pk_mul_f32 v[70:71], v[70:71], v[42:43] op_sel_hi:[1,0]
    v_pk_mul_f32 v[72:73], v[72:73], v[42:43] op_sel_hi:[1,0]
    v_pk_mul_f32 v[74:75], v[74:75], v[42:43] op_sel_hi:[1,0]
    v_pk_mul_f32 v[76:77], v[76:77], v[42:43] op_sel_hi:[1,0]
    v_pk_mul_f32 v[78:79], v[78:79], v[42:43] op_sel_hi:[1,0]
    v_pk_mul_f32 v[80:81], v[80:81], v[42:43] op_sel_hi:[1,0]
    v_pk_mul_f32 v[82:83], v[82:83], v[42:43] op_sel_hi:[1,0]
    v_pk_mul_f32 v[84:85], v[84:85], v[42:43] op_sel_hi:[1,0]
    v_pk_mul_f32 v[86:87], v[86:87], v[42:43] op_sel_hi:[1,0]
    v_pk_mul_f32 v[88:89], v[88:89], v[42:43] op_sel_hi:[1,0]
    v_pk_mul_f32 v[90:91], v[90:91], v[42:43] op_sel_hi:[1,0]
    v_pk_mul_f32 v[92:93], v[92:93], v[42:43] op_sel_hi:[1,0]
    v_pk_mul_f32 v[94:95], v[94:95], v[42:43] op_sel_hi:[1,0]
    s_branch A_backZ
A_dyn:
    s_cmp_ge_u32 s93, s34
    s_cbranch_scc1 A_phb
    s_cmp_lg_u32 s33, 0
    s_cbranch_scc1 A_dyn2
    s_mov_b32 s33, 1
    v_mov_b32 v15, 0
    s_barrier
    ds_read_b32 v15, v15 offset:8320
    s_lshl_b32 s94, s88, 2
    s_add_u32 s94, s94, s86
    s_sub_u32 s94, s94, 64
    v_lshlrev_b32 v42, 5, v1
    v_add_lshl_u32 v42, v42, s94, 2
    v_min_u32 v42, 8188, v42
    ds_read_b32 v8, v42
    s_waitcnt lgkmcnt(0)
    v_readfirstlane_b32 s89, v15
    v_readlane_b32 s32, v8, s93
    s_nop 0
    s_mul_i32 s94, s89, 28
    s_lshr_b32 s94, s94, 10
    s_lshl_b32 s3, s94, 5
    s_add_u32 s90, s94, 2
    s_add_u32 s94, s93, 1
    s_cmp_lt_u32 s94, s90
    s_cbranch_scc1 A_rec
    s_cmp_lg_u32 s93, s90
    s_cbranch_scc1 A_dyn2
    v_mov_b32 v42, 0
A_chk0:
    ds_read_b32 v13, v42 offset:8368
    s_waitcnt lgkmcnt(0)
    v_cmp_eq_u32 vcc, 0, v13
    s_cbranch_vccnz A_chk0
    s_mov_b32 s97, 1
    s_atomic_add s97, s[6:7], 0 glc
A_dyn2:
    s_cmp_lt_u32 s93, s90
    s_cbranch_scc1 A_first
    s_waitcnt lgkmcnt(0)
    s_add_u32 s95, s97, s3
    s_cmp_ge_u32 s95, s89
    s_cbranch_scc1 A_fini
    s_lshl_b32 s95, s95, 2
    v_mov_b32 v42, s95
    ds_read_b32 v42, v42
    s_waitcnt lgkmcnt(0)
    v_readfirstlane_b32 s32, v42
A_iss:
    s_mov_b32 s97, 1
    s_atomic_add s97, s[6:7], 0 glc
    s_branch A_rec
A_first:
    v_mov_b32 v42, 0
A_chk1:
    ds_read_b32 v13, v42 offset:8368
    s_waitcnt lgkmcnt(0)
    v_cmp_eq_u32 vcc, 0, v13
    s_cbranch_vccnz A_chk1
    s_branch A_iss
A_fini:
    s_mov_b32 s34, s93
    s_add_u32 s91, s93, 1
A_phb:
    s_sub_u32 s94, s93, s34
    v_readlane_b32 s32, v122, s94
    s_nop 1
    s_branch A_rec
P_start:
    s_setprio 3
    s_getpc_b64 s[40:41]
P_pc:
    s_sub_u32 s40, s40, P_pc-standalone__paged_block_table_kv_radixattention__sampling_kernel
    s_subb_u32 s41, s41, 0
    v_subrev_u32 v70, 256, v0
    v_lshlrev_b32 v70, 6, v70
    v_min_u32 v70, K_end-standalone__paged_block_table_kv_radixattention__sampling_kernel-4, v70
    global_load_dword v71, v70, s[40:41]
    v_subrev_u32 v64, 256, v0
    v_lshlrev_b32 v69, 2, v64
    v_mov_b32 v66, -1
    v_mov_b32 v68, 0
    ds_write_b32 v69, v68 offset:8192
    s_waitcnt lgkmcnt(0)
    s_load_dwordx16 s[4:19], s[0:1], 0
    s_barrier
    v_add_u32 v67, 4096, v69
    v_lshlrev_b32 v65, 16, v64
    s_sub_u32 s92, s86, 4
    v_lshlrev_b32 v6, 4, v1
    v_mov_b32 v84, 0x40000000
    v_cmp_gt_u32 vcc, 49, v1
    s_lshl_b32 s93, s96, 3
    s_lshl_b32 s94, s92, 1
    v_cndmask_b32 v6, v84, v6, vcc
    s_add_u32 s93, s93, s94
    s_lshl_b32 s93, s93, 3
    s_add_u32 s93, s93, s88
    s_mul_i32 s90, s93, 896
    s_add_u32 s91, s90, 7168
    s_cmp_eq_u32 s94, s88
    s_cselect_b32 s90, 0xf0000000, s90
    s_add_u32 s94, s94, 1
    s_cmp_eq_u32 s94, s88
    s_cselect_b32 s91, 0xf0000000, s91
    v_mov_b32 v8, -1
    v_mov_b32 v9, -1
    v_mov_b32 v10, -1
    v_mov_b32 v11, -1
    s_lshl_b32 s97, s96, 12
    s_add_u32 s97, s97, 1835008
    s_or_b32 s93, s88, s92
    s_cmp_eq_u32 s93, 0
    s_cselect_b32 s97, s97, 0xf0000000
    v_mov_b32 v12, 0
    s_mov_b32 s30, 1966080
    s_mov_b32 s31, 0x20000
    s_lshl_b32 s95, s96, 3
    v_mov_b32 v56, 0
    v_mov_b32 v57, 0
    v_mov_b32 v58, 0
    v_mov_b32 v59, 0
    v_mov_b32 v60, 0
    v_mov_b32 v61, 0
    v_mov_b32 v62, 0
    v_mov_b32 v63, 0
    s_mov_b64 s[58:59], 0
    s_mov_b64 s[60:61], 0
    s_mov_b64 s[62:63], 0
    s_mov_b64 s[64:65], 0
    s_mov_b64 s[66:67], 0
    s_mov_b64 s[68:69], 0
    s_mov_b64 s[70:71], 0
    s_waitcnt lgkmcnt(0)
    s_load_dwordx8 s[32:39], s[12:13], 0
    global_load_dword v48, v69, s[10:11] offset:0
    global_load_dword v49, v69, s[10:11] offset:1024
    global_load_dword v50, v69, s[10:11] offset:2048
    global_load_dword v51, v69, s[10:11] offset:3072
    global_load_dword v52, v67, s[10:11] offset:0
    global_load_dword v53, v67, s[10:11] offset:1024
    global_load_dword v54, v67, s[10:11] offset:2048
    global_load_dword v55, v67, s[10:11] offset:3072
    s_mov_b32 s28, s18
    s_and_b32 s29, s19, 0xffff
    buffer_store_dwordx4 v[8:11], v6, s[28:31], s90 offen sc1
    buffer_store_dwordx4 v[8:11], v6, s[28:31], s91 offen sc1
    buffer_store_dword v12, v12, s[28:31], s97 offen sc1
    s_add_u32 s16, s16, s95
    s_addc_u32 s17, s17, 0
    s_waitcnt lgkmcnt(0)
    s_cmp_lt_i32 s32, 1
    s_cselect_b32 s32, 0x1000, s32
    s_min_i32 s32, s32, 0x1000
    s_add_u32 s32, s32, 15
    s_lshr_b32 s32, s32, 4
    s_sub_u32 s32, s32, 16
    s_cmp_lt_i32 s33, 1
    s_cselect_b32 s33, 0x1000, s33
    s_min_i32 s33, s33, 0x1000
    s_add_u32 s33, s33, 15
    s_lshr_b32 s33, s33, 4
    s_sub_u32 s33, s33, 16
    s_cmp_lt_i32 s34, 1
    s_cselect_b32 s34, 0x1000, s34
    s_min_i32 s34, s34, 0x1000
    s_add_u32 s34, s34, 15
    s_lshr_b32 s34, s34, 4
    s_sub_u32 s34, s34, 16
    s_cmp_lt_i32 s35, 1
    s_cselect_b32 s35, 0x1000, s35
    s_min_i32 s35, s35, 0x1000
    s_add_u32 s35, s35, 15
    s_lshr_b32 s35, s35, 4
    s_sub_u32 s35, s35, 16
    s_cmp_lt_i32 s36, 1
    s_cselect_b32 s36, 0x1000, s36
    s_min_i32 s36, s36, 0x1000
    s_add_u32 s36, s36, 15
    s_lshr_b32 s36, s36, 4
    s_sub_u32 s36, s36, 16
    s_cmp_lt_i32 s37, 1
    s_cselect_b32 s37, 0x1000, s37
    s_min_i32 s37, s37, 0x1000
    s_add_u32 s37, s37, 15
    s_lshr_b32 s37, s37, 4
    s_sub_u32 s37, s37, 16
    s_cmp_lt_i32 s38, 1
    s_cselect_b32 s38, 0x1000, s38
    s_min_i32 s38, s38, 0x1000
    s_add_u32 s38, s38, 15
    s_lshr_b32 s38, s38, 4
    s_sub_u32 s38, s38, 16
    s_cmp_lt_i32 s39, 1
    s_cselect_b32 s39, 0x1000, s39
    s_min_i32 s39, s39, 0x1000
    s_add_u32 s39, s39, 15
    s_lshr_b32 s39, s39, 4
    s_sub_u32 s39, s39, 16
    v_cmp_gt_i32_e64 s[40:41], s32, v64
    v_cmp_gt_i32_e64 s[42:43], s33, v64
    v_cmp_gt_i32_e64 s[44:45], s34, v64
    v_cmp_gt_i32_e64 s[46:47], s35, v64
    v_cmp_gt_i32_e64 s[48:49], s36, v64
    v_cmp_gt_i32_e64 s[50:51], s37, v64
    v_cmp_gt_i32_e64 s[52:53], s38, v64
    v_cmp_gt_i32_e64 s[54:55], s39, v64
    s_waitcnt vmcnt(3)
    v_cndmask_b32_e64 v48, -1, v48, s[40:41]
    v_cndmask_b32_e64 v49, -2, v49, s[42:43]
    v_cndmask_b32_e64 v50, -3, v50, s[44:45]
    v_cndmask_b32_e64 v51, -4, v51, s[46:47]
    v_cndmask_b32_e64 v52, -5, v52, s[48:49]
    v_cndmask_b32_e64 v53, -6, v53, s[50:51]
    v_cndmask_b32_e64 v54, -7, v54, s[52:53]
    v_cndmask_b32_e64 v55, -8, v55, s[54:55]
    v_cmp_eq_u32_e64 s[72:73], v48, v55
    v_cmp_eq_u32_e64 s[74:75], v48, v54
    v_cmp_eq_u32_e64 s[76:77], v48, v53
    v_cmp_eq_u32_e64 s[78:79], v48, v52
    v_cmp_eq_u32_e64 s[80:81], v48, v51
    v_cmp_eq_u32_e64 s[82:83], v48, v50
    v_cmp_eq_u32_e64 s[84:85], v48, v49
    v_addc_co_u32_e64 v56, vcc, v56, v56, s[72:73]
    v_addc_co_u32_e64 v56, vcc, v56, v56, s[74:75]
    v_addc_co_u32_e64 v56, vcc, v56, v56, s[76:77]
    v_addc_co_u32_e64 v56, vcc, v56, v56, s[78:79]
    v_addc_co_u32_e64 v56, vcc, v56, v56, s[80:81]
    v_addc_co_u32_e64 v56, vcc, v56, v56, s[82:83]
    v_addc_co_u32_e64 v56, vcc, v56, v56, s[84:85]
    s_or_b64 s[70:71], s[70:71], s[72:73]
    s_or_b64 s[68:69], s[68:69], s[74:75]
    s_or_b64 s[66:67], s[66:67], s[76:77]
    s_or_b64 s[64:65], s[64:65], s[78:79]
    s_or_b64 s[62:63], s[62:63], s[80:81]
    s_or_b64 s[60:61], s[60:61], s[82:83]
    s_or_b64 s[58:59], s[58:59], s[84:85]
    v_cmp_eq_u32_e64 s[72:73], v49, v55
    v_cmp_eq_u32_e64 s[74:75], v49, v54
    v_cmp_eq_u32_e64 s[76:77], v49, v53
    v_cmp_eq_u32_e64 s[78:79], v49, v52
    v_cmp_eq_u32_e64 s[80:81], v49, v51
    v_cmp_eq_u32_e64 s[82:83], v49, v50
    v_addc_co_u32_e64 v57, vcc, v57, v57, s[72:73]
    v_addc_co_u32_e64 v57, vcc, v57, v57, s[74:75]
    v_addc_co_u32_e64 v57, vcc, v57, v57, s[76:77]
    v_addc_co_u32_e64 v57, vcc, v57, v57, s[78:79]
    v_addc_co_u32_e64 v57, vcc, v57, v57, s[80:81]
    v_addc_co_u32_e64 v57, vcc, v57, v57, s[82:83]
    s_or_b64 s[70:71], s[70:71], s[72:73]
    s_or_b64 s[68:69], s[68:69], s[74:75]
    s_or_b64 s[66:67], s[66:67], s[76:77]
    s_or_b64 s[64:65], s[64:65], s[78:79]
    s_or_b64 s[62:63], s[62:63], s[80:81]
    s_or_b64 s[60:61], s[60:61], s[82:83]
    v_cmp_eq_u32_e64 s[72:73], v50, v55
    v_cmp_eq_u32_e64 s[74:75], v50, v54
    v_cmp_eq_u32_e64 s[76:77], v50, v53
    v_cmp_eq_u32_e64 s[78:79], v50, v52
    v_cmp_eq_u32_e64 s[80:81], v50, v51
    v_addc_co_u32_e64 v58, vcc, v58, v58, s[72:73]
    v_addc_co_u32_e64 v58, vcc, v58, v58, s[74:75]
    v_addc_co_u32_e64 v58, vcc, v58, v58, s[76:77]
    v_addc_co_u32_e64 v58, vcc, v58, v58, s[78:79]
    v_addc_co_u32_e64 v58, vcc, v58, v58, s[80:81]
    s_or_b64 s[70:71], s[70:71], s[72:73]
    s_or_b64 s[68:69], s[68:69], s[74:75]
    s_or_b64 s[66:67], s[66:67], s[76:77]
    s_or_b64 s[64:65], s[64:65], s[78:79]
    s_or_b64 s[62:63], s[62:63], s[80:81]
    v_cmp_eq_u32_e64 s[72:73], v51, v55
    v_cmp_eq_u32_e64 s[74:75], v51, v54
    v_cmp_eq_u32_e64 s[76:77], v51, v53
    v_cmp_eq_u32_e64 s[78:79], v51, v52
    v_addc_co_u32_e64 v59, vcc, v59, v59, s[72:73]
    v_addc_co_u32_e64 v59, vcc, v59, v59, s[74:75]
    v_addc_co_u32_e64 v59, vcc, v59, v59, s[76:77]
    v_addc_co_u32_e64 v59, vcc, v59, v59, s[78:79]
    s_or_b64 s[70:71], s[70:71], s[72:73]
    s_or_b64 s[68:69], s[68:69], s[74:75]
    s_or_b64 s[66:67], s[66:67], s[76:77]
    s_or_b64 s[64:65], s[64:65], s[78:79]
    v_cmp_eq_u32_e64 s[72:73], v52, v55
    v_cmp_eq_u32_e64 s[74:75], v52, v54
    v_cmp_eq_u32_e64 s[76:77], v52, v53
    v_addc_co_u32_e64 v60, vcc, v60, v60, s[72:73]
    v_addc_co_u32_e64 v60, vcc, v60, v60, s[74:75]
    v_addc_co_u32_e64 v60, vcc, v60, v60, s[76:77]
    s_or_b64 s[70:71], s[70:71], s[72:73]
    s_or_b64 s[68:69], s[68:69], s[74:75]
    s_or_b64 s[66:67], s[66:67], s[76:77]
    v_cmp_eq_u32_e64 s[72:73], v53, v55
    v_cmp_eq_u32_e64 s[74:75], v53, v54
    s_nop 0
    v_addc_co_u32_e64 v61, vcc, v61, v61, s[72:73]
    v_addc_co_u32_e64 v61, vcc, v61, v61, s[74:75]
    s_or_b64 s[70:71], s[70:71], s[72:73]
    s_or_b64 s[68:69], s[68:69], s[74:75]
    v_cmp_eq_u32_e64 s[72:73], v54, v55
    s_nop 1
    v_addc_co_u32_e64 v62, vcc, v62, v62, s[72:73]
    s_or_b64 s[70:71], s[70:71], s[72:73]
    v_mov_b32 v68, 0
    s_bcnt1_i32_b64 s93, s[40:41]
    s_or_b32 s93, s93, 0x10000
    v_writelane_b32 v68, s93, 0
    s_andn2_b64 s[42:43], s[42:43], s[58:59]
    s_bcnt1_i32_b64 s93, s[42:43]
    s_or_b32 s93, s93, 0x10000
    v_writelane_b32 v68, s93, 1
    s_andn2_b64 s[44:45], s[44:45], s[60:61]
    s_bcnt1_i32_b64 s93, s[44:45]
    s_or_b32 s93, s93, 0x10000
    v_writelane_b32 v68, s93, 2
    s_andn2_b64 s[46:47], s[46:47], s[62:63]
    s_bcnt1_i32_b64 s93, s[46:47]
    s_or_b32 s93, s93, 0x10000
    v_writelane_b32 v68, s93, 3
    s_andn2_b64 s[48:49], s[48:49], s[64:65]
    s_bcnt1_i32_b64 s93, s[48:49]
    s_or_b32 s93, s93, 0x10000
    v_writelane_b32 v68, s93, 4
    s_andn2_b64 s[50:51], s[50:51], s[66:67]
    s_bcnt1_i32_b64 s93, s[50:51]
    s_or_b32 s93, s93, 0x10000
    v_writelane_b32 v68, s93, 5
    s_andn2_b64 s[52:53], s[52:53], s[68:69]
    s_bcnt1_i32_b64 s93, s[52:53]
    s_or_b32 s93, s93, 0x10000
    v_writelane_b32 v68, s93, 6
    s_andn2_b64 s[54:55], s[54:55], s[70:71]
    s_bcnt1_i32_b64 s93, s[54:55]
    s_or_b32 s93, s93, 0x10000
    v_writelane_b32 v68, s93, 7
    s_lshl_b32 s93, s92, 2
    s_add_u32 s93, s93, 8192
    v_lshl_add_u32 v66, v1, 4, s93
    s_mov_b64 exec, 0xff
    ds_write_b32 v66, v68
    s_mov_b64 exec, -1
    v_lshl_or_b32 v56, v56, 1, 1
    v_lshlrev_b32 v56, 24, v56
    v_or3_b32 v48, v48, v65, v56
    v_mbcnt_lo_u32_b32 v56, s40, 0
    v_mbcnt_hi_u32_b32 v56, s41, v56
    v_lshl_or_b32 v57, v57, 1, 1
    v_lshlrev_b32 v57, 25, v57
    v_or3_b32 v49, v49, v65, v57
    v_mbcnt_lo_u32_b32 v57, s42, 0
    v_mbcnt_hi_u32_b32 v57, s43, v57
    v_lshl_or_b32 v58, v58, 1, 1
    v_lshlrev_b32 v58, 26, v58
    v_or3_b32 v50, v50, v65, v58
    v_mbcnt_lo_u32_b32 v58, s44, 0
    v_mbcnt_hi_u32_b32 v58, s45, v58
    v_lshl_or_b32 v59, v59, 1, 1
    v_lshlrev_b32 v59, 27, v59
    v_or3_b32 v51, v51, v65, v59
    v_mbcnt_lo_u32_b32 v59, s46, 0
    v_mbcnt_hi_u32_b32 v59, s47, v59
    v_lshl_or_b32 v60, v60, 1, 1
    v_lshlrev_b32 v60, 28, v60
    v_or3_b32 v52, v52, v65, v60
    v_mbcnt_lo_u32_b32 v60, s48, 0
    v_mbcnt_hi_u32_b32 v60, s49, v60
    v_lshl_or_b32 v61, v61, 1, 1
    v_lshlrev_b32 v61, 29, v61
    v_or3_b32 v53, v53, v65, v61
    v_mbcnt_lo_u32_b32 v61, s50, 0
    v_mbcnt_hi_u32_b32 v61, s51, v61
    v_lshl_or_b32 v62, v62, 1, 1
    v_lshlrev_b32 v62, 30, v62
    v_or3_b32 v54, v54, v65, v62
    v_mbcnt_lo_u32_b32 v62, s52, 0
    v_mbcnt_hi_u32_b32 v62, s53, v62
    v_lshl_or_b32 v63, v63, 1, 1
    v_lshlrev_b32 v63, 31, v63
    v_or3_b32 v55, v55, v65, v63
    v_mbcnt_lo_u32_b32 v63, s54, 0
    v_mbcnt_hi_u32_b32 v63, s55, v63
    v_and_b32 v66, 31, v1
    v_lshlrev_b32 v66, 2, v66
P_cw:
    ds_read_b32 v68, v66 offset:8192
    s_waitcnt lgkmcnt(0)
    v_cmp_eq_u32 vcc, 0, v68
    s_cbranch_vccnz P_cw
    v_and_b32 v68, 0xffff, v68
    v_mov_b32 v67, v68
    s_nop 1
    v_add_u32_dpp v67, v67, v67 row_shr:1 row_mask:0xf bank_mask:0xf bound_ctrl:0
    s_nop 1
    v_add_u32_dpp v67, v67, v67 row_shr:2 row_mask:0xf bank_mask:0xf bound_ctrl:0
    s_nop 1
    v_add_u32_dpp v67, v67, v67 row_shr:4 row_mask:0xf bank_mask:0xf bound_ctrl:0
    s_nop 1
    v_add_u32_dpp v67, v67, v67 row_shr:8 row_mask:0xf bank_mask:0xf bound_ctrl:0
    s_nop 1
    v_add_u32_dpp v67, v67, v67 row_bcast:15 row_mask:0xa bank_mask:0xf
    s_nop 1
    v_readlane_b32 s89, v67, 31
    v_sub_u32 v67, v67, v68
    s_mov_b32 s94, s92
    v_readlane_b32 s72, v67, s94
    s_add_u32 s94, s94, 4
    v_readlane_b32 s73, v67, s94
    s_add_u32 s94, s94, 4
    v_readlane_b32 s74, v67, s94
    s_add_u32 s94, s94, 4
    v_readlane_b32 s75, v67, s94
    s_add_u32 s94, s94, 4
    v_readlane_b32 s76, v67, s94
    s_add_u32 s94, s94, 4
    v_readlane_b32 s77, v67, s94
    s_add_u32 s94, s94, 4
    v_readlane_b32 s78, v67, s94
    s_add_u32 s94, s94, 4
    v_readlane_b32 s79, v67, s94
    s_add_u32 s94, s94, 4
    v_mov_b32 v66, 0
    v_mov_b32 v68, s89
    ds_write_b32 v66, v68 offset:8320
    v_add_lshl_u32 v56, v56, s72, 2
    v_add_lshl_u32 v57, v57, s73, 2
    v_add_lshl_u32 v58, v58, s74, 2
    v_add_lshl_u32 v59, v59, s75, 2
    v_add_lshl_u32 v60, v60, s76, 2
    v_add_lshl_u32 v61, v61, s77, 2
    v_add_lshl_u32 v62, v62, s78, 2
    v_add_lshl_u32 v63, v63, s79, 2
    s_mov_b64 exec, s[40:41]
    ds_write_b32 v56, v48
    s_mov_b64 exec, s[42:43]
    ds_write_b32 v57, v49
    s_mov_b64 exec, s[44:45]
    ds_write_b32 v58, v50
    s_mov_b64 exec, s[46:47]
    ds_write_b32 v59, v51
    s_mov_b64 exec, s[48:49]
    ds_write_b32 v60, v52
    s_mov_b64 exec, s[50:51]
    ds_write_b32 v61, v53
    s_mov_b64 exec, s[52:53]
    ds_write_b32 v62, v54
    s_mov_b64 exec, s[54:55]
    ds_write_b32 v63, v55
    s_mov_b64 exec, -1
    s_waitcnt vmcnt(0) lgkmcnt(0)
    s_barrier
    v_lshlrev_b32 v5, 4, v1
    v_and_b32 v10, 3, v1
    v_lshlrev_b32 v10, 2, v10
    v_min_u32 v5, 752, v5
    s_mul_i32 s93, s92, 1568
    v_add_u32 v81, s93, v5
    s_lshl_b32 s93, s92, 4
    v_mov_b32 v11, s93
    v_cmp_eq_u32_e64 s[36:37], 48, v1
    s_cmp_lg_u32 s92, 0
    s_cbranch_scc1 H_wa0
    s_mov_b32 s95, 1
    s_mov_b32 s8, 0
H_chk:
    s_mov_b32 s94, s95
    s_atomic_add s95, s[16:17], 0 glc
    s_add_u32 s8, s8, 1
    s_waitcnt lgkmcnt(0)
    s_add_u32 s94, s94, s95
    s_mov_b32 s95, 0
    s_cmp_ge_u32 s94, 8
    s_cbranch_scc1 H_chkok
    s_cmp_ge_u32 s8, 65536
    s_cbranch_scc1 H_chkok
    s_sleep 32
    s_branch H_chk
H_chkok:
    v_mov_b32 v12, 0
    v_mov_b32 v13, 1
    ds_write_b32 v12, v13 offset:8368
    s_mov_b32 s20, s14
    s_and_b32 s21, s15, 0xffff
    s_mov_b32 s22, 98304
    s_mov_b32 s23, 0x20000
    v_cmp_gt_u32 vcc, 48, v1
    v_lshrrev_b32 v13, 2, v1
    v_and_b32 v18, 3, v1
    v_cndmask_b32_e64 v12, v84, 0, vcc
    v_lshl_add_u32 v14, v18, 5, v13
    v_lshl_add_u32 v15, v18, 4, v13
    v_add_u32 v15, 120, v15
    v_cmp_gt_u32 vcc, 8, v13
    v_mov_b32 v16, 8
    v_mov_b32 v17, 16
    v_cndmask_b32 v14, v15, v14, vcc
    v_cndmask_b32 v17, v16, v17, vcc
    v_lshl_add_u32 v14, v14, 1, v12
    v_add_u32 v15, v14, v17
    v_add_u32 v16, v15, v17
    v_add_u32 v17, v16, v17
    v_mov_b32 v18, 0
H_wa0:
    s_mov_b32 s8, 0
H_wa:
    ds_read_b32 v13, v10 offset:8336
    s_add_u32 s8, s8, 1
    s_waitcnt lgkmcnt(0)
    v_cmp_eq_u32 vcc, 0, v13
    s_cmp_ge_u32 s8, 67108864
    s_cbranch_scc1 H_wa_ok
    s_cbranch_vccz H_wa_ok
    s_sleep 4
    s_branch H_wa
H_wa_ok:
    ds_read_b128 v[24:27], v11 offset:15424
    ds_read_b128 v[28:31], v11 offset:15488
    ds_read_b128 v[32:35], v11 offset:15552
    ds_read_b128 v[36:39], v11 offset:15616
    ds_read_b128 v[40:43], v81 offset:15680
    ds_read_b128 v[44:47], v81 offset:21952
    ds_read_b128 v[48:51], v81 offset:28224
    ds_read_b128 v[52:55], v81 offset:34496
    ds_read_b128 v[56:59], v81 offset:16464
    ds_read_b128 v[60:63], v81 offset:22736
    ds_read_b128 v[64:67], v81 offset:29008
    ds_read_b128 v[68:71], v81 offset:35280
    s_waitcnt lgkmcnt(8)
    v_max3_f32 v7, v24, v28, v32
    v_max_f32 v7, v7, v36
    v_sub_f32 v24, v24, v7
    v_sub_f32 v28, v28, v7
    v_sub_f32 v32, v32, v7
    v_sub_f32 v36, v36, v7
    v_exp_f32 v24, v24
    v_exp_f32 v28, v28
    v_exp_f32 v32, v32
    v_exp_f32 v36, v36
    v_mul_f32 v19, v24, v25
    v_fmac_f32 v19, v28, v29
    v_fmac_f32 v19, v32, v33
    v_fmac_f32 v19, v36, v37
    s_waitcnt lgkmcnt(4)
    v_mul_f32 v72, v24, v40
    v_mul_f32 v73, v24, v41
    v_mul_f32 v74, v24, v42
    v_mul_f32 v75, v24, v43
    v_fmac_f32 v72, v28, v44
    v_fmac_f32 v73, v28, v45
    v_fmac_f32 v74, v28, v46
    v_fmac_f32 v75, v28, v47
    v_fmac_f32 v72, v32, v48
    v_fmac_f32 v73, v32, v49
    v_fmac_f32 v74, v32, v50
    v_fmac_f32 v75, v32, v51
    v_fmac_f32 v72, v36, v52
    v_fmac_f32 v73, v36, v53
    v_fmac_f32 v74, v36, v54
    v_fmac_f32 v75, v36, v55
    v_cndmask_b32_e64 v72, v72, v7, s[36:37]
    v_cndmask_b32_e64 v73, v73, v19, s[36:37]
    v_min_u32 v72, -2, v72
    v_min_u32 v73, -2, v73
    v_min_u32 v74, -2, v74
    v_min_u32 v75, -2, v75
    buffer_store_dwordx4 v[72:75], v6, s[28:31], s90 offen sc1
    v_max3_f32 v7, v26, v30, v34
    v_max_f32 v7, v7, v38
    v_sub_f32 v26, v26, v7
    v_sub_f32 v30, v30, v7
    v_sub_f32 v34, v34, v7
    v_sub_f32 v38, v38, v7
    v_exp_f32 v26, v26
    v_exp_f32 v30, v30
    v_exp_f32 v34, v34
    v_exp_f32 v38, v38
    v_mul_f32 v19, v26, v27
    v_fmac_f32 v19, v30, v31
    v_fmac_f32 v19, v34, v35
    v_fmac_f32 v19, v38, v39
    s_waitcnt lgkmcnt(0)
    v_mul_f32 v76, v26, v56
    v_mul_f32 v77, v26, v57
    v_mul_f32 v78, v26, v58
    v_mul_f32 v79, v26, v59
    v_fmac_f32 v76, v30, v60
    v_fmac_f32 v77, v30, v61
    v_fmac_f32 v78, v30, v62
    v_fmac_f32 v79, v30, v63
    v_fmac_f32 v76, v34, v64
    v_fmac_f32 v77, v34, v65
    v_fmac_f32 v78, v34, v66
    v_fmac_f32 v79, v34, v67
    v_fmac_f32 v76, v38, v68
    v_fmac_f32 v77, v38, v69
    v_fmac_f32 v78, v38, v70
    v_fmac_f32 v79, v38, v71
    v_cndmask_b32_e64 v76, v76, v7, s[36:37]
    v_cndmask_b32_e64 v77, v77, v19, s[36:37]
    v_min_u32 v76, -2, v76
    v_min_u32 v77, -2, v77
    v_min_u32 v78, -2, v78
    v_min_u32 v79, -2, v79
    buffer_store_dwordx4 v[76:79], v6, s[28:31], s91 offen sc1
    s_cmp_eq_u32 s92, 0
    s_cbranch_scc1 H_start
    s_endpgm
H_start:
    s_mul_i32 s34, s2, 7168
    s_lshl_b32 s32, 1, s88
    s_xor_b32 s32, s32, 0xff
    s_mov_b32 s8, 0
    v_mov_b32 v40, 0
    v_mov_b32 v41, 0
    v_mov_b32 v42, 0
    v_mov_b32 v43, 0
    v_mov_b32 v44, 0
    v_mov_b32 v45, 0
    v_mov_b32 v46, 0
    v_mov_b32 v47, 0
    v_mov_b32 v48, 0
    v_mov_b32 v49, 0
    v_mov_b32 v50, 0
    v_mov_b32 v51, 0
    v_mov_b32 v52, 0
    v_mov_b32 v53, 0
    v_mov_b32 v54, 0
    v_mov_b32 v55, 0
    v_mov_b32 v56, 0
    v_mov_b32 v57, 0
    v_mov_b32 v58, 0
    v_mov_b32 v59, 0
    v_mov_b32 v60, 0
    v_mov_b32 v61, 0
    v_mov_b32 v62, 0
    v_mov_b32 v63, 0
    v_mov_b32 v64, 0
    v_mov_b32 v65, 0
    v_mov_b32 v66, 0
    v_mov_b32 v67, 0
    v_mov_b32 v68, 0
    v_mov_b32 v69, 0
    v_mov_b32 v70, 0
    v_mov_b32 v71, 0
H_poll:
    s_bitcmp1_b32 s32, 0
    s_cbranch_scc0 H_sk0
    buffer_load_dwordx4 v[40:43], v6, s[28:31], s34 offen offset:0 sc1
H_sk0:
    s_bitcmp1_b32 s32, 1
    s_cbranch_scc0 H_sk1
    buffer_load_dwordx4 v[44:47], v6, s[28:31], s34 offen offset:896 sc1
H_sk1:
    s_bitcmp1_b32 s32, 2
    s_cbranch_scc0 H_sk2
    buffer_load_dwordx4 v[48:51], v6, s[28:31], s34 offen offset:1792 sc1
H_sk2:
    s_bitcmp1_b32 s32, 3
    s_cbranch_scc0 H_sk3
    buffer_load_dwordx4 v[52:55], v6, s[28:31], s34 offen offset:2688 sc1
H_sk3:
    s_bitcmp1_b32 s32, 4
    s_cbranch_scc0 H_sk4
    buffer_load_dwordx4 v[56:59], v6, s[28:31], s34 offen offset:3584 sc1
H_sk4:
    s_bitcmp1_b32 s32, 5
    s_cbranch_scc0 H_sk5
    s_add_u32 s35, s34, 4480
    buffer_load_dwordx4 v[60:63], v6, s[28:31], s35 offen sc1
H_sk5:
    s_bitcmp1_b32 s32, 6
    s_cbranch_scc0 H_sk6
    s_add_u32 s35, s34, 5376
    buffer_load_dwordx4 v[64:67], v6, s[28:31], s35 offen sc1
H_sk6:
    s_bitcmp1_b32 s32, 7
    s_cbranch_scc0 H_sk7
    s_add_u32 s35, s34, 6272
    buffer_load_dwordx4 v[68:71], v6, s[28:31], s35 offen sc1
H_sk7:
    s_add_u32 s8, s8, 1
    s_mov_b32 s32, 0
    s_waitcnt vmcnt(0)
    v_max3_u32 v24, v40, v41, v42
    v_max3_u32 v25, v44, v45, v46
    v_max3_u32 v26, v48, v49, v50
    v_max3_u32 v27, v52, v53, v54
    v_max3_u32 v28, v56, v57, v58
    v_max3_u32 v29, v60, v61, v62
    v_max3_u32 v30, v64, v65, v66
    v_max3_u32 v31, v68, v69, v70
    v_max_u32 v24, v24, v43
    v_max_u32 v25, v25, v47
    v_max_u32 v26, v26, v51
    v_max_u32 v27, v27, v55
    v_max_u32 v28, v28, v59
    v_max_u32 v29, v29, v63
    v_max_u32 v30, v30, v67
    v_max_u32 v31, v31, v71
    v_cmp_eq_u32_e64 s[40:41], -1, v24
    v_cmp_eq_u32_e64 s[42:43], -1, v25
    v_cmp_eq_u32_e64 s[44:45], -1, v26
    v_cmp_eq_u32_e64 s[46:47], -1, v27
    v_cmp_eq_u32_e64 s[48:49], -1, v28
    v_cmp_eq_u32_e64 s[50:51], -1, v29
    v_cmp_eq_u32_e64 s[52:53], -1, v30
    v_cmp_eq_u32_e64 s[54:55], -1, v31
    s_cmp_lg_u64 s[40:41], 0
    s_cselect_b32 s35, 1, 0
    s_or_b32 s32, s32, s35
    s_cmp_lg_u64 s[42:43], 0
    s_cselect_b32 s35, 2, 0
    s_or_b32 s32, s32, s35
    s_cmp_lg_u64 s[44:45], 0
    s_cselect_b32 s35, 4, 0
    s_or_b32 s32, s32, s35
    s_cmp_lg_u64 s[46:47], 0
    s_cselect_b32 s35, 8, 0
    s_or_b32 s32, s32, s35
    s_cmp_lg_u64 s[48:49], 0
    s_cselect_b32 s35, 16, 0
    s_or_b32 s32, s32, s35
    s_cmp_lg_u64 s[50:51], 0
    s_cselect_b32 s35, 32, 0
    s_or_b32 s32, s32, s35
    s_cmp_lg_u64 s[52:53], 0
    s_cselect_b32 s35, 64, 0
    s_or_b32 s32, s32, s35
    s_cmp_lg_u64 s[54:55], 0
    s_cselect_b32 s35, 128, 0
    s_or_b32 s32, s32, s35
    s_cbranch_scc0 H_gath
    s_cmp_ge_u32 s8, 131072
    s_cbranch_scc0 H_poll
H_gath:
    v_readlane_b32 s40, v40, 48
    v_readlane_b32 s41, v41, 48
    v_readlane_b32 s42, v44, 48
    v_readlane_b32 s43, v45, 48
    v_readlane_b32 s44, v48, 48
    v_readlane_b32 s45, v49, 48
    v_readlane_b32 s46, v52, 48
    v_readlane_b32 s47, v53, 48
    v_readlane_b32 s48, v56, 48
    v_readlane_b32 s49, v57, 48
    v_readlane_b32 s50, v60, 48
    v_readlane_b32 s51, v61, 48
    v_readlane_b32 s52, v64, 48
    v_readlane_b32 s53, v65, 48
    v_readlane_b32 s54, v68, 48
    v_readlane_b32 s55, v69, 48
    s_cmp_eq_u32 s88, 0
    s_cselect_b32 s40, 0xff61b1e6, s40
    s_cmp_eq_u32 s88, 1
    s_cselect_b32 s42, 0xff61b1e6, s42
    s_cmp_eq_u32 s88, 2
    s_cselect_b32 s44, 0xff61b1e6, s44
    s_cmp_eq_u32 s88, 3
    s_cselect_b32 s46, 0xff61b1e6, s46
    s_cmp_eq_u32 s88, 4
    s_cselect_b32 s48, 0xff61b1e6, s48
    s_cmp_eq_u32 s88, 5
    s_cselect_b32 s50, 0xff61b1e6, s50
    s_cmp_eq_u32 s88, 6
    s_cselect_b32 s52, 0xff61b1e6, s52
    s_cmp_eq_u32 s88, 7
    s_cselect_b32 s54, 0xff61b1e6, s54
    v_mov_b32 v7, s40
    v_max_f32 v7, s42, v7
    v_max_f32 v7, s44, v7
    v_max_f32 v7, s46, v7
    v_max_f32 v7, s48, v7
    v_max_f32 v7, s50, v7
    v_max_f32 v7, s52, v7
    v_max_f32 v7, s54, v7
    v_sub_f32 v24, s40, v7
    v_sub_f32 v25, s42, v7
    v_sub_f32 v26, s44, v7
    v_sub_f32 v27, s46, v7
    v_sub_f32 v28, s48, v7
    v_sub_f32 v29, s50, v7
    v_sub_f32 v30, s52, v7
    v_sub_f32 v31, s54, v7
    v_exp_f32 v24, v24
    v_exp_f32 v25, v25
    v_exp_f32 v26, v26
    v_exp_f32 v27, v27
    v_exp_f32 v28, v28
    v_exp_f32 v29, v29
    v_exp_f32 v30, v30
    v_exp_f32 v31, v31
    v_mul_f32 v19, s41, v24
    v_fmac_f32 v19, s43, v25
    v_fmac_f32 v19, s45, v26
    v_fmac_f32 v19, s47, v27
    v_fmac_f32 v19, s49, v28
    v_fmac_f32 v19, s51, v29
    v_fmac_f32 v19, s53, v30
    v_fmac_f32 v19, s55, v31
    v_mul_f32 v20, v24, v40
    v_mul_f32 v21, v24, v41
    v_mul_f32 v22, v24, v42
    v_mul_f32 v23, v24, v43
    v_fmac_f32 v20, v25, v44
    v_fmac_f32 v21, v25, v45
    v_fmac_f32 v22, v25, v46
    v_fmac_f32 v23, v25, v47
    v_fmac_f32 v20, v26, v48
    v_fmac_f32 v21, v26, v49
    v_fmac_f32 v22, v26, v50
    v_fmac_f32 v23, v26, v51
    v_fmac_f32 v20, v27, v52
    v_fmac_f32 v21, v27, v53
    v_fmac_f32 v22, v27, v54
    v_fmac_f32 v23, v27, v55
    v_fmac_f32 v20, v28, v56
    v_fmac_f32 v21, v28, v57
    v_fmac_f32 v22, v28, v58
    v_fmac_f32 v23, v28, v59
    v_fmac_f32 v20, v29, v60
    v_fmac_f32 v21, v29, v61
    v_fmac_f32 v22, v29, v62
    v_fmac_f32 v23, v29, v63
    v_fmac_f32 v20, v30, v64
    v_fmac_f32 v21, v30, v65
    v_fmac_f32 v22, v30, v66
    v_fmac_f32 v23, v30, v67
    v_fmac_f32 v20, v31, v68
    v_fmac_f32 v21, v31, v69
    v_fmac_f32 v22, v31, v70
    v_fmac_f32 v23, v31, v71
    s_lshl_b32 s93, s88, 5
    s_add_u32 s93, s93, s96
    s_mul_i32 s93, s93, 384
    s_mov_b32 s8, 0
H_wb:
    ds_read_b32 v13, v10 offset:8352
    s_add_u32 s8, s8, 1
    s_waitcnt lgkmcnt(0)
    v_cmp_eq_u32 vcc, 0, v13
    s_cmp_ge_u32 s8, 67108864
    s_cbranch_scc1 H_wb_ok
    s_cbranch_vccnz H_wb
H_wb_ok:
    ds_read_b128 v[24:27], v18 offset:15360
    ds_read_b128 v[28:31], v18 offset:15376
    ds_read_b128 v[40:43], v5 offset:12288
    ds_read_b128 v[44:47], v5 offset:13056
    ds_read_b128 v[48:51], v5 offset:13824
    ds_read_b128 v[52:55], v5 offset:14592
    s_waitcnt lgkmcnt(4)
    v_max3_f32 v11, v24, v26, v7
    v_max3_f32 v11, v28, v30, v11
    v_sub_f32 v7, v7, v11
    v_sub_f32 v24, v24, v11
    v_sub_f32 v26, v26, v11
    v_sub_f32 v28, v28, v11
    v_sub_f32 v30, v30, v11
    v_exp_f32 v7, v7
    v_exp_f32 v24, v24
    v_exp_f32 v26, v26
    v_exp_f32 v28, v28
    v_exp_f32 v30, v30
    v_mul_f32 v19, v19, v7
    v_fmac_f32 v19, v24, v25
    v_fmac_f32 v19, v26, v27
    v_fmac_f32 v19, v28, v29
    v_fmac_f32 v19, v30, v31
    v_mul_f32 v20, v20, v7
    v_mul_f32 v21, v21, v7
    v_mul_f32 v22, v22, v7
    v_mul_f32 v23, v23, v7
    v_rcp_f32 v19, v19
    s_waitcnt lgkmcnt(0)
    v_fmac_f32 v20, v24, v40
    v_fmac_f32 v21, v24, v41
    v_fmac_f32 v22, v24, v42
    v_fmac_f32 v23, v24, v43
    v_fmac_f32 v20, v26, v44
    v_fmac_f32 v21, v26, v45
    v_fmac_f32 v22, v26, v46
    v_fmac_f32 v23, v26, v47
    v_fmac_f32 v20, v28, v48
    v_fmac_f32 v21, v28, v49
    v_fmac_f32 v22, v28, v50
    v_fmac_f32 v23, v28, v51
    v_fmac_f32 v20, v30, v52
    v_fmac_f32 v21, v30, v53
    v_fmac_f32 v22, v30, v54
    v_fmac_f32 v23, v30, v55
    v_mul_f32 v20, v20, v19
    v_mul_f32 v21, v21, v19
    v_mul_f32 v22, v22, v19
    v_mul_f32 v23, v23, v19
    v_cvt_pk_bf16_f32 v12, v20, v21
    v_cvt_pk_bf16_f32 v13, v22, v23
    buffer_store_short v12, v14, s[20:23], s93 offen
    buffer_store_short_d16_hi v12, v15, s[20:23], s93 offen
    buffer_store_short v13, v16, s[20:23], s93 offen
    buffer_store_short_d16_hi v13, v17, s[20:23], s93 offen
    s_endpgm
K_end:
.section .rodata,"a"
.p2align 6
.amdhsa_kernel standalone__paged_block_table_kv_radixattention__sampling_kernel
  .amdhsa_next_free_vgpr 172
  .amdhsa_next_free_sgpr 102
  .amdhsa_accum_offset 148
  .amdhsa_group_segment_fixed_size 0
  .amdhsa_kernarg_size 64
  .amdhsa_user_sgpr_count 2
  .amdhsa_user_sgpr_kernarg_segment_ptr 1
  .amdhsa_system_sgpr_workgroup_id_x 1
.end_amdhsa_kernel
```
